```python
import torch

def _softmax(x, axis=-1):
    return torch.softmax(x, dim=axis)
def _gelu(x):
    return torch.nn.functional.gelu(x, approximate="tanh")
def _silu(x):
    return torch.nn.functional.silu(x)
def _sigmoid(x):
    return torch.sigmoid(x)
def _layernorm(x, axis=-1, eps=1e-5):
    m = x.mean(dim=axis, keepdim=True)
    v = x.var(dim=axis, keepdim=True, unbiased=False)
    return (x - m) / torch.sqrt(v + eps)
def _scatter_add(tgt, idx, src, axis=0):
    return tgt.clone().index_add_(axis, idx, src)
def _segment_sum(src, seg, n):
    out = torch.zeros((n,) + src.shape[1:], dtype=src.dtype)
    return out.index_add_(0, seg, src)
def _pad(x, pw):
    flat = tuple(v for pair in reversed(pw) for v in pair)
    return torch.nn.functional.pad(x, flat)

kernel_name = 'standalone__edge_featured_mpnn_egc__graph'

def setup_inputs():

    _w = (lambda a: (lambda t: t.to(torch.bfloat16) if t.is_floating_point() else t)(torch.as_tensor(a)))
    N, deg, D, De = 50000, 16, 64, max(16, 1)
    E = N * deg
    return {
        "x": _w((lambda *s: torch.randn(*s, dtype=torch.bfloat16) * 0.2)(N, D)),
        "e_attr": _w((lambda *s: torch.randn(*s, dtype=torch.bfloat16) * 0.2)(E, De)),
        "src": _w((lambda lo, hi, *s: torch.randint(lo, hi, s))(0, N, E).to(torch.int64)),
        "dst": _w((lambda lo, hi, *s: torch.randint(lo, hi, s))(0, N, E).to(torch.int64)),
        "u_w": _w((lambda *s: torch.randn(*s, dtype=torch.bfloat16) * 0.05)(D, D)),
        "v_w": _w((lambda *s: torch.randn(*s, dtype=torch.bfloat16) * 0.05)(D, D)),
        "g_w": _w((lambda *s: torch.randn(*s, dtype=torch.bfloat16) * 0.2)(2 * D + De, D)),
    }

def reference(x, e_attr, src, dst, u_w, v_w, g_w):
    N, D = x.shape
    g_in = torch.concatenate([x[dst], x[src], e_attr], axis=-1)
    eta = _sigmoid(g_in @ g_w)
    hv = x @ v_w
    msg = eta * hv[src]
    agg = _segment_sum(msg, dst, N)
    return _silu(x @ u_w + agg)
```

```asm
; @launch grid=(256,1,1) block=(512,1,1) lds=150080
.amdgcn_target "amdgcn-amd-amdhsa--gfx950"
.text
.p2align 8
.globl standalone__edge_featured_mpnn_egc__graph_kernel
.type standalone__edge_featured_mpnn_egc__graph_kernel,@function
standalone__edge_featured_mpnn_egc__graph_kernel:
    s_cmp_ge_u32 s2, 256
    s_cbranch_scc1 K2_end
    s_and_b32 s3, s2, 7
    s_lshl_b32 s3, s3, 5
    s_lshr_b32 s4, s2, 3
    s_add_u32 s3, s3, s4
    s_cmp_ge_u32 s3, 250
    s_cbranch_scc1 K2_end
    s_load_dwordx16 s[40:55], s[0:1], 0
    s_load_dwordx4 s[56:59], s[0:1], 64
    s_memrealtime s[60:61]
    v_lshrrev_b32 v22, 6, v0
    v_and_b32 v23, 63, v0
    v_readfirstlane_b32 s4, v22
    v_lshlrev_b32 v1, 4, v23
    v_lshlrev_b32 v88, 4, v0
    v_cmp_gt_u32 vcc, 0x120, v0
    v_mov_b32 v28, 0x7ffffff0
    v_add_u32 v89, 0x2000, v88
    s_mul_i32 s31, s3, 12800
    v_cndmask_b32 v89, v28, v89, vcc
    s_mov_b64 s[28:29], vcc
    s_setprio 1
    s_waitcnt lgkmcnt(0)
    s_mov_b32 s32, s46
    s_and_b32 s33, s47, 0xffff
    s_mov_b32 s34, 0x30d400
    s_mov_b32 s35, 0x20000
    buffer_load_dwordx4 v[32:35], v88, s[32:35], s31 offen nt
    buffer_load_dwordx4 v[36:39], v89, s[32:35], s31 offen nt
    s_mov_b32 s36, s44
    s_and_b32 s37, s45, 0xffff
    s_mov_b32 s38, 0x30d400
    s_mov_b32 s39, 0x20000
    buffer_load_dwordx4 v[40:43], v88, s[36:39], s31 offen nt
    buffer_load_dwordx4 v[44:47], v89, s[36:39], s31 offen nt
    s_mov_b32 s8, s40
    s_and_b32 s9, s41, 0xffff
    s_mov_b32 s10, 0x61a800
    s_mov_b32 s11, 0x20000
    s_mov_b32 s12, s42
    s_and_b32 s13, s43, 0xffff
    s_mov_b32 s14, 0x186a000
    s_mov_b32 s15, 0x20000
    s_mov_b32 s16, s54
    s_and_b32 s17, s55, 0xffff
    s_mov_b32 s18, 0x61a800
    s_mov_b32 s19, 0x20000
    s_mov_b32 s20, s58
    s_and_b32 s21, s59, 0xffff
    s_mov_b32 s22, 0x10000000
    s_mov_b32 s23, 0x20000
    s_mov_b32 s40, s56
    s_and_b32 s41, s57, 0xffff
    s_mov_b32 s42, 0x100
    s_mov_b32 s43, 0x20000
    v_and_b32 v19, 31, v23
    v_lshrrev_b32 v18, 5, v23
    v_lshlrev_b32 v10, 4, v18
    v_mov_b32 v15, 0
    s_or_b32 s31, s3, s4
    s_cmp_lg_u32 s31, 0
    s_cbranch_scc1 F_notag
    s_and_b32 s61, s61, 0xff
    s_or_b32 s61, s61, 0x100
    v_mov_b32 v30, s60
    v_mov_b32 v31, s61
    s_mov_b64 exec, 1
    buffer_store_dwordx2 v[30:31], v15, s[40:43], 0 offen sc1
    s_mov_b64 exec, -1
F_notag:
    s_mul_i32 s24, s4, 5120
    s_add_u32 s24, s24, 23104
    v_and_b32 v22, 7, v23
    v_lshlrev_b32 v2, 2, v18
    v_xor_b32 v2, v2, v22
    v_lshlrev_b32 v2, 4, v2
    s_mul_i32 s68, s3, 200
    s_mul_i32 s31, s4, 25
    s_add_u32 s68, s68, s31
    s_lshl_b32 s68, s68, 7
    s_mov_b32 s25, 0x1fffffe0
    s_movk_i32 s26, 80
    s_mov_b32 s66, 0xbfb8aa3b
    s_mov_b32 s7, 0
    v_mov_b32 v14, 0x3f80
    v_and_b32 v22, 19, v19
    v_and_b32 v20, 4, v19
    v_lshl_or_b32 v22, v20, 1, v22
    v_and_b32 v20, 8, v19
    v_lshrrev_b32 v20, 1, v20
    v_or_b32 v22, v22, v20
    v_lshlrev_b32 v22, 1, v22
    s_mul_i32 s31, s4, 2560
    s_add_u32 s31, s31, 2624
    v_add_u32 v12, s31, v22
    v_mad_u32_u24 v20, v19, s26, v10
    v_add_u32 v13, s31, v20
    v_add_u32 v11, 64, v10
    v_mov_b32 v30, 0
    v_mov_b32 v31, 0
    v_lshlrev_b32 v21, 3, v23
    s_cmp_lg_u32 s4, 7
    s_cbranch_scc1 F_noinit
    v_add_u32 v20, 105024, v21
    ds_write_b64 v20, v[30:31]
    ds_write_b64 v20, v[30:31] offset:512
    v_and_b32 v29, 7, v23
    v_mul_u32_u24 v20, 2816, v29
    v_add_u32 v20, 105024, v20
    v_lshlrev_b32 v29, 2, v29
    ds_write_b32 v29, v20 offset:0
    ds_write_b32 v29, v15 offset:32
    ds_write_b64 v21, v[30:31] offset:64
    ds_write_b64 v21, v[30:31] offset:576
    ds_write_b64 v21, v[30:31] offset:1088
    ds_write_b64 v21, v[30:31] offset:1600
    ds_write_b64 v21, v[30:31] offset:2112
    v_mad_u32_u24 v20, v19, s26, v22
    ds_write_b16 v20, v14 offset:64
F_noinit:
    v_add_u32 v20, s31, v21
    ds_write_b64 v20, v[30:31] offset:0
    ds_write_b64 v20, v[30:31] offset:512
    ds_write_b64 v20, v[30:31] offset:1024
    ds_write_b64 v20, v[30:31] offset:1536
    ds_write_b64 v20, v[30:31] offset:2048
    v_and_b32 v20, 1, v23
    v_xor_b32 v20, v20, v18
    v_lshlrev_b32 v16, 4, v20
    v_lshrrev_b32 v20, 4, v19
    v_xor_b32 v20, v20, v18
    v_lshlrev_b32 v20, 4, v20
    v_lshl_add_u32 v20, v19, 5, v20
    v_add_u32 v3, s24, v20
    v_add_u32 v3, 0x1000, v3
    v_and_b32 v20, 3, v19
    v_lshrrev_b32 v21, 4, v19
    v_lshl_add_u32 v21, v21, 2, v20
    v_xor_b32 v21, v21, v18
    v_lshlrev_b32 v21, 4, v21
    v_lshlrev_b32 v20, 10, v20
    v_lshrrev_b32 v22, 2, v19
    v_lshl_add_u32 v20, v22, 7, v20
    v_add_u32 v20, s24, v20
    s_movk_i32 s65, 96
    v_xad_u32 v4, v21, 0, v20
    v_xad_u32 v5, v21, 32, v20
    v_xad_u32 v6, v21, 64, v20
    v_xad_u32 v7, v21, s65, v20
    s_mul_i32 s31, s4, 2816
    s_add_u32 s31, s31, 105024
    v_lshrrev_b32 v20, 3, v23
    v_lshlrev_b32 v20, 4, v20
    v_add_u32 v8, s31, v20
    v_lshlrev_b32 v20, 2, v19
    v_add_u32 v20, s31, v20
    v_add_u32 v9, 22528, v20
    v_lshrrev_b32 v20, 1, v23
    v_lshlrev_b32 v20, 2, v20
    v_add_u32 v20, s31, v20
    v_add_u32 v17, 22528, v20
    s_lshr_b32 s31, s2, 3
    s_lshl_b32 s31, s31, 13
    v_lshlrev_b32 v25, 7, v23
    v_add_u32 v25, s31, v25
    s_mov_b32 s69, 83887
    s_mul_i32 s31, s3, 102400
    v_lshlrev_b32 v90, 7, v0
    v_add_u32 v90, s31, v90
    v_add_u32 v91, 0x10000, v90
    v_mov_b32 v92, 1
    s_waitcnt lgkmcnt(0)
    s_barrier
    v_lshrrev_b32 v22, 3, v23
    v_lshlrev_b32 v22, 9, v22
    s_mov_b32 m0, s24
    s_mov_b32 s31, s68
    v_xad_u32 v232, v2, 0, v22
    buffer_load_dwordx4 v232, s[8:11], s31 offen nt lds
    s_add_u32 m0, m0, 0x400
    s_add_u32 s31, s31, 128
    v_xad_u32 v233, v2, 16, v22
    buffer_load_dwordx4 v233, s[8:11], s31 offen nt lds
    s_add_u32 m0, m0, 0x400
    s_add_u32 s31, s31, 128
    v_xad_u32 v234, v2, 32, v22
    buffer_load_dwordx4 v234, s[8:11], s31 offen nt lds
    s_add_u32 m0, m0, 0x400
    s_add_u32 s31, s31, 128
    v_xad_u32 v235, v2, 48, v22
    buffer_load_dwordx4 v235, s[8:11], s31 offen nt lds
    s_add_u32 m0, m0, 0x400
    s_add_u32 s31, s31, 128
    s_waitcnt vmcnt(6)
    v_mul_u32_u24 v48, s69, v32
    v_mul_u32_u24 v49, s69, v33
    v_mul_u32_u24 v50, s69, v34
    v_mul_u32_u24 v51, s69, v35
    v_mul_u32_u24 v52, s69, v36
    v_mul_u32_u24 v53, s69, v37
    v_mul_u32_u24 v54, s69, v38
    v_mul_u32_u24 v55, s69, v39
    v_lshrrev_b32 v56, 24, v48
    v_lshrrev_b32 v57, 24, v49
    v_lshrrev_b32 v58, 24, v50
    v_lshrrev_b32 v59, 24, v51
    v_lshrrev_b32 v60, 24, v52
    v_lshrrev_b32 v61, 24, v53
    v_lshrrev_b32 v62, 24, v54
    v_lshrrev_b32 v63, 24, v55
    v_lshlrev_b32 v56, 2, v56
    v_lshlrev_b32 v57, 2, v57
    v_lshlrev_b32 v58, 2, v58
    v_lshlrev_b32 v59, 2, v59
    v_lshlrev_b32 v60, 2, v60
    v_lshlrev_b32 v61, 2, v61
    v_lshlrev_b32 v62, 2, v62
    v_lshlrev_b32 v63, 2, v63
    v_add_u32 v56, 105024, v56
    v_add_u32 v57, 105024, v57
    v_add_u32 v58, 105024, v58
    v_add_u32 v59, 105024, v59
    v_add_u32 v60, 105024, v60
    v_add_u32 v61, 105024, v61
    v_add_u32 v62, 105024, v62
    v_add_u32 v63, 105024, v63
    ds_add_rtn_u32 v64, v56, v92
    ds_add_rtn_u32 v65, v57, v92
    ds_add_rtn_u32 v66, v58, v92
    ds_add_rtn_u32 v67, v59, v92
    s_mov_b64 exec, s[28:29]
    ds_add_rtn_u32 v68, v60, v92
    ds_add_rtn_u32 v69, v61, v92
    ds_add_rtn_u32 v70, v62, v92
    ds_add_rtn_u32 v71, v63, v92
    s_mov_b64 exec, -1
    v_lshlrev_b32 v20, 2, v19
    v_lshl_add_u32 v20, v18, 10, v20
    s_add_u32 s31, s4, 0
    s_cmp_lt_u32 s31, 13
    s_cselect_b32 s60, s50, s48
    s_cselect_b32 s61, s51, s49
    s_cselect_b32 s64, 9, 13
    s_cmp_lt_u32 s31, 9
    s_cselect_b32 s60, s52, s60
    s_cselect_b32 s61, s53, s61
    s_cselect_b32 s64, 0, s64
    s_movk_i32 s65, 0x2000
    s_cselect_b32 s62, 0x4800, s65
    s_and_b32 s61, s61, 0xffff
    s_mov_b32 s63, 0x20000
    s_sub_u32 s64, s31, s64
    s_lshl_b32 s64, s64, 11
    buffer_load_dword v152, v20, s[60:63], s64 offen offset:0
    buffer_load_dword v153, v20, s[60:63], s64 offen offset:128
    buffer_load_dword v154, v20, s[60:63], s64 offen offset:256
    buffer_load_dword v155, v20, s[60:63], s64 offen offset:384
    buffer_load_dword v156, v20, s[60:63], s64 offen offset:512
    buffer_load_dword v157, v20, s[60:63], s64 offen offset:640
    buffer_load_dword v158, v20, s[60:63], s64 offen offset:768
    buffer_load_dword v159, v20, s[60:63], s64 offen offset:896
    s_add_u32 s31, s4, 8
    s_cmp_lt_u32 s31, 13
    s_cselect_b32 s60, s50, s48
    s_cselect_b32 s61, s51, s49
    s_cselect_b32 s64, 9, 13
    s_cmp_lt_u32 s31, 9
    s_cselect_b32 s60, s52, s60
    s_cselect_b32 s61, s53, s61
    s_cselect_b32 s64, 0, s64
    s_movk_i32 s65, 0x2000
    s_cselect_b32 s62, 0x4800, s65
    s_and_b32 s61, s61, 0xffff
    s_mov_b32 s63, 0x20000
    s_sub_u32 s64, s31, s64
    s_lshl_b32 s64, s64, 11
    buffer_load_dword v160, v20, s[60:63], s64 offen offset:0
    buffer_load_dword v161, v20, s[60:63], s64 offen offset:128
    buffer_load_dword v162, v20, s[60:63], s64 offen offset:256
    buffer_load_dword v163, v20, s[60:63], s64 offen offset:384
    buffer_load_dword v164, v20, s[60:63], s64 offen offset:512
    buffer_load_dword v165, v20, s[60:63], s64 offen offset:640
    buffer_load_dword v166, v20, s[60:63], s64 offen offset:768
    buffer_load_dword v167, v20, s[60:63], s64 offen offset:896
    s_cmp_lg_u32 s4, 0
    s_cbranch_scc1 F_now3
    s_mov_b32 s31, 16
    s_cmp_lt_u32 s31, 13
    s_cselect_b32 s60, s50, s48
    s_cselect_b32 s61, s51, s49
    s_cselect_b32 s64, 9, 13
    s_cmp_lt_u32 s31, 9
    s_cselect_b32 s60, s52, s60
    s_cselect_b32 s61, s53, s61
    s_cselect_b32 s64, 0, s64
    s_movk_i32 s65, 0x2000
    s_cselect_b32 s62, 0x4800, s65
    s_and_b32 s61, s61, 0xffff
    s_mov_b32 s63, 0x20000
    s_sub_u32 s64, s31, s64
    s_lshl_b32 s64, s64, 11
    buffer_load_dword v168, v20, s[60:63], s64 offen offset:0
    buffer_load_dword v169, v20, s[60:63], s64 offen offset:128
    buffer_load_dword v170, v20, s[60:63], s64 offen offset:256
    buffer_load_dword v171, v20, s[60:63], s64 offen offset:384
    buffer_load_dword v172, v20, s[60:63], s64 offen offset:512
    buffer_load_dword v173, v20, s[60:63], s64 offen offset:640
    buffer_load_dword v174, v20, s[60:63], s64 offen offset:768
    buffer_load_dword v175, v20, s[60:63], s64 offen offset:896
F_now3:
    s_movk_i32 s65, 96
    v_lshrrev_b32 v48, 21, v48
    v_lshrrev_b32 v49, 21, v49
    v_lshrrev_b32 v50, 21, v50
    v_lshrrev_b32 v51, 21, v51
    v_lshrrev_b32 v52, 21, v52
    v_lshrrev_b32 v53, 21, v53
    v_lshrrev_b32 v54, 21, v54
    v_lshrrev_b32 v55, 21, v55
    v_mul_u32_u24 v96, 25, v48
    v_mul_u32_u24 v97, 25, v49
    v_mul_u32_u24 v98, 25, v50
    v_mul_u32_u24 v99, 25, v51
    v_mul_u32_u24 v100, 25, v52
    v_mul_u32_u24 v101, 25, v53
    v_mul_u32_u24 v102, 25, v54
    v_mul_u32_u24 v103, 25, v55
    v_sub_u32 v32, v32, v96
    v_sub_u32 v33, v33, v97
    v_sub_u32 v34, v34, v98
    v_sub_u32 v35, v35, v99
    v_sub_u32 v36, v36, v100
    v_sub_u32 v37, v37, v101
    v_sub_u32 v38, v38, v102
    v_sub_u32 v39, v39, v103
    v_lshl_or_b32 v32, v48, 29, v32
    v_lshl_or_b32 v33, v49, 29, v33
    v_lshl_or_b32 v34, v50, 29, v34
    v_lshl_or_b32 v35, v51, 29, v35
    v_lshl_or_b32 v36, v52, 29, v36
    v_lshl_or_b32 v37, v53, 29, v37
    v_lshl_or_b32 v38, v54, 29, v38
    v_lshl_or_b32 v39, v55, 29, v39
    v_add3_u32 v73, v90, v32, 0
    v_add3_u32 v75, v90, v33, 32
    v_add3_u32 v77, v90, v34, 64
    v_add3_u32 v79, v90, v35, s65
    v_add3_u32 v81, v91, v36, 0
    v_add3_u32 v83, v91, v37, 32
    v_add3_u32 v85, v91, v38, 64
    v_add3_u32 v87, v91, v39, s65
    s_waitcnt lgkmcnt(0)
    s_barrier
    s_cmp_lg_u32 s4, 0
    s_cbranch_scc1 F_noscan
    v_add_u32 v117, 105024, v1
    ds_read_b128 v[104:107], v117
    s_waitcnt lgkmcnt(0)
    v_add_u32 v108, v104, v105
    v_add_u32 v109, v108, v106
    v_add_u32 v110, v109, v107
    v_mov_b32 v111, v110
    s_nop 1
    v_add_u32_dpp v111, v111, v111 row_shr:1 row_mask:0xf bank_mask:0xf
    s_nop 1
    v_add_u32_dpp v111, v111, v111 row_shr:2 row_mask:0xf bank_mask:0xf
    s_nop 1
    v_add_u32_dpp v111, v111, v111 row_shr:4 row_mask:0xf bank_mask:0xf
    s_nop 1
    v_add_u32_dpp v111, v111, v111 row_shr:8 row_mask:0xf bank_mask:0xf
    s_nop 1
    v_add_u32_dpp v111, v111, v111 row_bcast:15 row_mask:0xa bank_mask:0xf
    s_nop 1
    v_add_u32_dpp v111, v111, v111 row_bcast:31 row_mask:0xc bank_mask:0xf
    v_sub_u32 v112, v111, v110
    v_add_u32 v113, v112, v104
    v_add_u32 v114, v112, v108
    v_add_u32 v115, v112, v109
    ds_write_b128 v117, v[112:115] offset:1024
    v_lshl_or_b32 v236, v104, 12, v112
    v_lshl_or_b32 v238, v105, 12, v113
    v_lshl_or_b32 v240, v106, 12, v114
    v_lshl_or_b32 v242, v107, 12, v115
    s_waitcnt lgkmcnt(0)
F_noscan:
    s_waitcnt vmcnt(20)
    v_lshlrev_b32 v72, 7, v40
    v_lshlrev_b32 v74, 7, v41
    v_lshlrev_b32 v76, 7, v42
    v_lshlrev_b32 v78, 7, v43
    v_lshlrev_b32 v80, 7, v44
    v_lshlrev_b32 v82, 7, v45
    v_lshlrev_b32 v84, 7, v46
    v_lshlrev_b32 v86, 7, v47
    s_barrier
    ds_read_b32 v48, v56 offset:1024
    ds_read_b32 v49, v57 offset:1024
    ds_read_b32 v50, v58 offset:1024
    ds_read_b32 v51, v59 offset:1024
    ds_read_b32 v52, v60 offset:1024
    ds_read_b32 v53, v61 offset:1024
    ds_read_b32 v54, v62 offset:1024
    ds_read_b32 v55, v63 offset:1024
    buffer_load_dwordx2 v[244:245], v15, s[40:43], 0 offen sc1
    s_waitcnt lgkmcnt(0)
    v_add_lshl_u32 v48, v48, v64, 3
    v_add_lshl_u32 v49, v49, v65, 3
    v_add_lshl_u32 v50, v50, v66, 3
    v_add_lshl_u32 v51, v51, v67, 3
    v_add_lshl_u32 v52, v52, v68, 3
    v_add_lshl_u32 v53, v53, v69, 3
    v_add_lshl_u32 v54, v54, v70, 3
    v_add_lshl_u32 v55, v55, v71, 3
    v_add_u32 v48, 107072, v48
    v_add_u32 v49, 107072, v49
    v_add_u32 v50, 107072, v50
    v_add_u32 v51, 107072, v51
    v_add_u32 v52, 107072, v52
    v_add_u32 v53, 107072, v53
    v_add_u32 v54, 107072, v54
    v_add_u32 v55, 107072, v55
    ds_write_b64 v48, v[72:73]
    ds_write_b64 v49, v[74:75]
    ds_write_b64 v50, v[76:77]
    ds_write_b64 v51, v[78:79]
    s_mov_b64 exec, s[28:29]
    ds_write_b64 v52, v[80:81]
    ds_write_b64 v53, v[82:83]
    ds_write_b64 v54, v[84:85]
    ds_write_b64 v55, v[86:87]
    s_mov_b64 exec, -1
    v_add_u32 v93, 107072, v88
    v_cmp_gt_u32 vcc, 64, v0
    v_add_u32 v94, 0x6000, v88
    s_mul_i32 s69, s3, 25728
    v_cndmask_b32 v94, v28, v94, vcc
    v_add_u32 v95, 0x2000, v88
    v_add_u32 v96, 0x4000, v88
    s_waitcnt lgkmcnt(0)
    s_barrier
    ds_read_b128 v[32:35], v93 offset:0
    ds_read_b128 v[36:39], v93 offset:8192
    ds_read_b128 v[40:43], v93 offset:16384
    ds_read_b128 v[44:47], v93 offset:24576
    s_waitcnt lgkmcnt(3)
    buffer_store_dwordx4 v[32:35], v88, s[20:23], s69 offen sc1
    s_waitcnt lgkmcnt(2)
    buffer_store_dwordx4 v[36:39], v95, s[20:23], s69 offen sc1
    s_waitcnt lgkmcnt(1)
    buffer_store_dwordx4 v[40:43], v96, s[20:23], s69 offen sc1
    s_waitcnt lgkmcnt(0)
    buffer_store_dwordx4 v[44:47], v94, s[20:23], s69 offen sc1
    s_waitcnt vmcnt(4)
    s_mov_b32 s69, 0
F_tagchk:
    v_readfirstlane_b32 s57, v245
    v_readfirstlane_b32 s56, v244
    s_nop 3
    s_cmp_lg_u32 s57, 0
    s_cbranch_scc1 F_tagok
    s_add_u32 s69, s69, 1
    s_cmp_ge_u32 s69, 1048576
    s_cbranch_scc1 F_tagok
    s_sleep 2
    buffer_load_dwordx2 v[244:245], v15, s[40:43], 0 offen sc1
    s_waitcnt vmcnt(0)
    s_branch F_tagchk
F_tagok:
    s_and_b32 s57, s57, 0xff
    s_waitcnt vmcnt(0)
    s_barrier
    s_cmp_lg_u32 s4, 0
    s_cbranch_scc1 F_notab
    s_lshl_b32 s31, s57, 24
    v_or_b32 v236, s31, v236
    v_mov_b32 v237, s56
    v_or_b32 v238, s31, v238
    v_mov_b32 v239, s56
    v_or_b32 v240, s31, v240
    v_mov_b32 v241, s56
    v_or_b32 v242, s31, v242
    v_mov_b32 v243, s56
    s_lshl_b32 s31, s3, 11
    s_add_u32 s31, s31, 0x700000
    v_lshlrev_b32 v22, 1, v1
    buffer_store_dwordx4 v[236:239], v22, s[20:23], s31 offen sc1
    buffer_store_dwordx4 v[240:243], v22, s[20:23], s31 offen offset:16 sc1
F_notab:
    s_mov_b32 s64, 0x05040100
    s_mov_b32 s65, 0x07060302
    s_lshl_b32 s31, s4, 11
    v_add_u32 v22, s31, v1
    v_add_u32 v22, 64064, v22
    s_cmp_ge_u32 s4, 4
    s_cbranch_scc1 F_p0s
    v_perm_b32 v120, v153, v152, s64
    v_perm_b32 v124, v153, v152, s65
    v_perm_b32 v121, v155, v154, s64
    v_perm_b32 v125, v155, v154, s65
    v_perm_b32 v122, v157, v156, s64
    v_perm_b32 v126, v157, v156, s65
    v_perm_b32 v123, v159, v158, s64
    v_perm_b32 v127, v159, v158, s65
    s_branch F_p0d
F_p0s:
    v_lshlrev_b32 v184, 16, v152
    v_and_b32 v192, 0xffff0000, v152
    v_lshlrev_b32 v185, 16, v153
    v_and_b32 v193, 0xffff0000, v153
    v_lshlrev_b32 v186, 16, v154
    v_and_b32 v194, 0xffff0000, v154
    v_lshlrev_b32 v187, 16, v155
    v_and_b32 v195, 0xffff0000, v155
    v_lshlrev_b32 v188, 16, v156
    v_and_b32 v196, 0xffff0000, v156
    v_lshlrev_b32 v189, 16, v157
    v_and_b32 v197, 0xffff0000, v157
    v_lshlrev_b32 v190, 16, v158
    v_and_b32 v198, 0xffff0000, v158
    v_lshlrev_b32 v191, 16, v159
    v_and_b32 v199, 0xffff0000, v159
    v_mul_f32 v184, s66, v184
    v_mul_f32 v185, s66, v185
    v_mul_f32 v186, s66, v186
    v_mul_f32 v187, s66, v187
    v_mul_f32 v188, s66, v188
    v_mul_f32 v189, s66, v189
    v_mul_f32 v190, s66, v190
    v_mul_f32 v191, s66, v191
    v_mul_f32 v192, s66, v192
    v_mul_f32 v193, s66, v193
    v_mul_f32 v194, s66, v194
    v_mul_f32 v195, s66, v195
    v_mul_f32 v196, s66, v196
    v_mul_f32 v197, s66, v197
    v_mul_f32 v198, s66, v198
    v_mul_f32 v199, s66, v199
    v_cvt_pk_bf16_f32 v120, v184, v185
    v_cvt_pk_bf16_f32 v124, v192, v193
    v_cvt_pk_bf16_f32 v121, v186, v187
    v_cvt_pk_bf16_f32 v125, v194, v195
    v_cvt_pk_bf16_f32 v122, v188, v189
    v_cvt_pk_bf16_f32 v126, v196, v197
    v_cvt_pk_bf16_f32 v123, v190, v191
    v_cvt_pk_bf16_f32 v127, v198, v199
F_p0d:
    ds_write_b128 v22, v[120:123] offset:0
    ds_write_b128 v22, v[124:127] offset:1024
    s_cmp_eq_u32 s4, 0
    s_cbranch_scc1 F_p1w0
    v_perm_b32 v128, v161, v160, s64
    v_perm_b32 v132, v161, v160, s65
    v_perm_b32 v129, v163, v162, s64
    v_perm_b32 v133, v163, v162, s65
    v_perm_b32 v130, v165, v164, s64
    v_perm_b32 v134, v165, v164, s65
    v_perm_b32 v131, v167, v166, s64
    v_perm_b32 v135, v167, v166, s65
    ds_write_b128 v22, v[128:131] offset:16384
    ds_write_b128 v22, v[132:135] offset:17408
    s_branch F_p1d
F_p1w0:
    v_lshlrev_b32 v184, 16, v160
    v_and_b32 v192, 0xffff0000, v160
    v_lshlrev_b32 v185, 16, v161
    v_and_b32 v193, 0xffff0000, v161
    v_lshlrev_b32 v186, 16, v162
    v_and_b32 v194, 0xffff0000, v162
    v_lshlrev_b32 v187, 16, v163
    v_and_b32 v195, 0xffff0000, v163
    v_lshlrev_b32 v188, 16, v164
    v_and_b32 v196, 0xffff0000, v164
    v_lshlrev_b32 v189, 16, v165
    v_and_b32 v197, 0xffff0000, v165
    v_lshlrev_b32 v190, 16, v166
    v_and_b32 v198, 0xffff0000, v166
    v_lshlrev_b32 v191, 16, v167
    v_and_b32 v199, 0xffff0000, v167
    v_mul_f32 v184, s66, v184
    v_mul_f32 v185, s66, v185
    v_mul_f32 v186, s66, v186
    v_mul_f32 v187, s66, v187
    v_mul_f32 v188, s66, v188
    v_mul_f32 v189, s66, v189
    v_mul_f32 v190, s66, v190
    v_mul_f32 v191, s66, v191
    v_mul_f32 v192, s66, v192
    v_mul_f32 v193, s66, v193
    v_mul_f32 v194, s66, v194
    v_mul_f32 v195, s66, v195
    v_mul_f32 v196, s66, v196
    v_mul_f32 v197, s66, v197
    v_mul_f32 v198, s66, v198
    v_mul_f32 v199, s66, v199
    v_cvt_pk_bf16_f32 v128, v184, v185
    v_cvt_pk_bf16_f32 v132, v192, v193
    v_cvt_pk_bf16_f32 v129, v186, v187
    v_cvt_pk_bf16_f32 v133, v194, v195
    v_cvt_pk_bf16_f32 v130, v188, v189
    v_cvt_pk_bf16_f32 v134, v196, v197
    v_cvt_pk_bf16_f32 v131, v190, v191
    v_cvt_pk_bf16_f32 v135, v198, v199
    ds_write_b128 v22, v[128:131] offset:16384
    ds_write_b128 v22, v[132:135] offset:17408
    v_perm_b32 v136, v169, v168, s64
    v_perm_b32 v140, v169, v168, s65
    v_perm_b32 v137, v171, v170, s64
    v_perm_b32 v141, v171, v170, s65
    v_perm_b32 v138, v173, v172, s64
    v_perm_b32 v142, v173, v172, s65
    v_perm_b32 v139, v175, v174, s64
    v_perm_b32 v143, v175, v174, s65
    ds_write_b128 v22, v[136:139] offset:32768
    ds_write_b128 v22, v[140:143] offset:33792
F_p1d:
    v_mov_b32 v200, 0x7fffff80
    v_mov_b32 v204, 0x1ffffff9
    v_mov_b32 v201, 0x7fffff80
    v_mov_b32 v205, 0x1ffffff9
    v_mov_b32 v202, 0x7fffff80
    v_mov_b32 v206, 0x1ffffff9
    v_mov_b32 v203, 0x7fffff80
    v_mov_b32 v207, 0x1ffffff9
    v_lshlrev_b32 v208, 4, v0
    v_add_u32 v209, 0x4000, v208
    v_min_u32 v209, 22512, v209
    v_add_u32 v208, 105024, v208
    v_add_u32 v209, 105024, v209
    ds_write_b128 v208, v[200:203] offset:0
    ds_write_b128 v208, v[200:203] offset:8192
    ds_write_b128 v209, v[200:203] offset:0
    ds_write_b128 v208, v[204:207] offset:22528
    ds_write_b128 v208, v[204:207] offset:30720
    ds_write_b128 v209, v[204:207] offset:22528
    s_waitcnt lgkmcnt(0)
    s_barrier
    v_add_u32 v22, 64064, v1
    ds_read_b128 v[184:187], v22 offset:26624
    ds_read_b128 v[200:203], v22 offset:27648
    ds_read_b128 v[188:191], v22 offset:28672
    ds_read_b128 v[204:207], v22 offset:29696
    ds_read_b128 v[192:195], v22 offset:30720
    ds_read_b128 v[208:211], v22 offset:31744
    ds_read_b128 v[196:199], v22 offset:32768
    ds_read_b128 v[212:215], v22 offset:33792
    ds_read_b128 v[152:155], v22 offset:0
    ds_read_b128 v[168:171], v22 offset:1024
    ds_read_b128 v[156:159], v22 offset:2048
    ds_read_b128 v[172:175], v22 offset:3072
    ds_read_b128 v[160:163], v22 offset:4096
    ds_read_b128 v[176:179], v22 offset:5120
    ds_read_b128 v[164:167], v22 offset:6144
    ds_read_b128 v[180:183], v22 offset:7168
    ds_read_b128 v[32:35], v22 offset:8192
    ds_read_b128 v[36:39], v22 offset:9216
    ds_read_b128 v[40:43], v22 offset:10240
    ds_read_b128 v[44:47], v22 offset:11264
    ds_read_b128 v[48:51], v22 offset:12288
    ds_read_b128 v[52:55], v22 offset:13312
    ds_read_b128 v[56:59], v22 offset:14336
    ds_read_b128 v[60:63], v22 offset:15360
    ds_read_b128 v[64:67], v22 offset:16384
    ds_read_b128 v[68:71], v22 offset:17408
    ds_read_b128 v[72:75], v22 offset:18432
    ds_read_b128 v[76:79], v22 offset:19456
    ds_read_b128 v[80:83], v22 offset:20480
    ds_read_b128 v[84:87], v22 offset:21504
    ds_read_b128 v[88:91], v22 offset:22528
    ds_read_b128 v[92:95], v22 offset:23552
    ds_read_b128 v[96:99], v22 offset:24576
    ds_read_b128 v[100:103], v22 offset:25600
    s_lshl_b32 s67, s3, 3
    s_add_u32 s67, s67, 0x700000
    s_add_u32 s44, s67, 0x0
    s_add_u32 s45, s67, 0x20000
    s_add_u32 s46, s67, 0x40000
    s_add_u32 s47, s67, 0x60000
    v_lshrrev_b32 v20, 3, v0
    v_and_b32 v21, 7, v0
    v_lshlrev_b32 v21, 1, v21
    v_cmp_gt_u32 s[50:51], 58, v20
    v_lshlrev_b32 v29, 11, v20
    v_mul_u32_u24 v20, 3216, v20
    v_cndmask_b32 v30, v28, v29, s[50:51]
    v_add_u32 v20, v20, v21
    buffer_load_dwordx2 v[236:237], v29, s[20:23], s44 offen sc1
    buffer_load_dwordx2 v[238:239], v29, s[20:23], s45 offen sc1
    buffer_load_dwordx2 v[240:241], v29, s[20:23], s46 offen sc1
    buffer_load_dwordx2 v[242:243], v30, s[20:23], s47 offen sc1
    ds_read_b128 v[216:219], v4
    ds_read_b128 v[220:223], v5
    ds_read_b128 v[224:227], v6
    ds_read_b128 v[228:231], v7
    s_waitcnt lgkmcnt(0)
    v_mfma_f32_32x32x16_bf16 v[120:135], v[216:219], v[184:187], 0
    v_mfma_f32_32x32x16_bf16 v[120:135], v[220:223], v[188:191], v[120:135]
    v_mfma_f32_32x32x16_bf16 v[120:135], v[224:227], v[192:195], v[120:135]
    v_mfma_f32_32x32x16_bf16 v[120:135], v[228:231], v[196:199], v[120:135]
    v_mfma_f32_32x32x16_bf16 v[136:151], v[216:219], v[200:203], 0
    v_mfma_f32_32x32x16_bf16 v[136:151], v[220:223], v[204:207], v[136:151]
    v_mfma_f32_32x32x16_bf16 v[136:151], v[224:227], v[208:211], v[136:151]
    v_mfma_f32_32x32x16_bf16 v[136:151], v[228:231], v[212:215], v[136:151]
    v_mfma_f32_32x32x16_bf16 v[184:199], v[216:219], v[152:155], 0
    v_mfma_f32_32x32x16_bf16 v[184:199], v[220:223], v[156:159], v[184:199]
    v_mfma_f32_32x32x16_bf16 v[184:199], v[224:227], v[160:163], v[184:199]
    v_mfma_f32_32x32x16_bf16 v[184:199], v[228:231], v[164:167], v[184:199]
    v_mfma_f32_32x32x16_bf16 v[200:215], v[216:219], v[168:171], 0
    v_mfma_f32_32x32x16_bf16 v[200:215], v[220:223], v[172:175], v[200:215]
    v_mfma_f32_32x32x16_bf16 v[200:215], v[224:227], v[176:179], v[200:215]
    v_mfma_f32_32x32x16_bf16 v[200:215], v[228:231], v[180:183], v[200:215]
    s_nop 7
    v_mul_f32 v184, s66, v184
    v_mul_f32 v185, s66, v185
    v_mul_f32 v186, s66, v186
    v_mul_f32 v187, s66, v187
    v_mul_f32 v188, s66, v188
    v_mul_f32 v189, s66, v189
    v_mul_f32 v190, s66, v190
    v_mul_f32 v191, s66, v191
    v_mul_f32 v192, s66, v192
    v_mul_f32 v193, s66, v193
    v_mul_f32 v194, s66, v194
    v_mul_f32 v195, s66, v195
    v_mul_f32 v196, s66, v196
    v_mul_f32 v197, s66, v197
    v_mul_f32 v198, s66, v198
    v_mul_f32 v199, s66, v199
    v_cvt_pk_bf16_f32 v104, v184, v185
    v_cvt_pk_bf16_f32 v105, v186, v187
    v_cvt_pk_bf16_f32 v106, v188, v189
    v_cvt_pk_bf16_f32 v107, v190, v191
    v_cvt_pk_bf16_f32 v112, v192, v193
    v_cvt_pk_bf16_f32 v113, v194, v195
    v_cvt_pk_bf16_f32 v114, v196, v197
    v_cvt_pk_bf16_f32 v115, v198, v199
    v_mul_f32 v200, s66, v200
    v_mul_f32 v201, s66, v201
    v_mul_f32 v202, s66, v202
    v_mul_f32 v203, s66, v203
    v_mul_f32 v204, s66, v204
    v_mul_f32 v205, s66, v205
    v_mul_f32 v206, s66, v206
    v_mul_f32 v207, s66, v207
    v_mul_f32 v208, s66, v208
    v_mul_f32 v209, s66, v209
    v_mul_f32 v210, s66, v210
    v_mul_f32 v211, s66, v211
    v_mul_f32 v212, s66, v212
    v_mul_f32 v213, s66, v213
    v_mul_f32 v214, s66, v214
    v_mul_f32 v215, s66, v215
    v_cvt_pk_bf16_f32 v108, v200, v201
    v_cvt_pk_bf16_f32 v109, v202, v203
    v_cvt_pk_bf16_f32 v110, v204, v205
    v_cvt_pk_bf16_f32 v111, v206, v207
    v_cvt_pk_bf16_f32 v116, v208, v209
    v_cvt_pk_bf16_f32 v117, v210, v211
    v_cvt_pk_bf16_f32 v118, v212, v213
    v_cvt_pk_bf16_f32 v119, v214, v215
    s_mov_b32 s69, 0
F_poll:
    s_waitcnt vmcnt(0)
    v_xor_b32 v244, s56, v237
    v_lshrrev_b32 v248, 24, v236
    v_xor_b32 v248, s57, v248
    v_xor_b32 v245, s56, v239
    v_lshrrev_b32 v249, 24, v238
    v_xor_b32 v249, s57, v249
    v_xor_b32 v246, s56, v241
    v_lshrrev_b32 v250, 24, v240
    v_xor_b32 v250, s57, v250
    v_xor_b32 v247, s56, v243
    v_lshrrev_b32 v251, 24, v242
    v_xor_b32 v251, s57, v251
    v_or_b32 v247, v247, v251
    v_cndmask_b32 v247, 0, v247, s[50:51]
    v_or3_b32 v244, v244, v245, v246
    v_or3_b32 v248, v248, v249, v250
    v_or3_b32 v244, v244, v247, v248
    v_cmp_ne_u32 vcc, 0, v244
    s_cbranch_vccz F_polled
    s_add_u32 s69, s69, 1
    s_cmp_ge_u32 s69, 1048576
    s_cbranch_scc1 F_polled
    buffer_load_dwordx2 v[236:237], v29, s[20:23], s44 offen sc1
    buffer_load_dwordx2 v[238:239], v29, s[20:23], s45 offen sc1
    buffer_load_dwordx2 v[240:241], v29, s[20:23], s46 offen sc1
    buffer_load_dwordx2 v[242:243], v30, s[20:23], s47 offen sc1
    s_branch F_poll
F_polled:
    v_bfe_u32 v248, v236, 12, 12
    v_sub_u32 v248, v248, v21
    v_and_b32 v244, 0xfff, v236
    v_add_u32 v244, 0, v244
    v_add_lshl_u32 v244, v244, v20, 3
    v_bfe_u32 v249, v238, 12, 12
    v_sub_u32 v249, v249, v21
    v_and_b32 v245, 0xfff, v238
    v_add_u32 v245, 205824, v245
    v_add_lshl_u32 v245, v245, v20, 3
    v_bfe_u32 v250, v240, 12, 12
    v_sub_u32 v250, v250, v21
    v_and_b32 v246, 0xfff, v240
    v_add_u32 v246, 411648, v246
    v_add_lshl_u32 v246, v246, v20, 3
    v_bfe_u32 v251, v242, 12, 12
    v_sub_u32 v251, v251, v21
    v_and_b32 v247, 0xfff, v242
    v_add_u32 v247, 617472, v247
    v_add_lshl_u32 v247, v247, v20, 3
    v_mov_b32 v22, 4
    s_mov_b32 s69, 127548
K2_collect:
    v_cmp_lt_i32 s[32:33], 0, v248
    v_cmp_lt_i32 s[36:37], 16, v248
    v_cmp_lt_i32 s[40:41], 0, v249
    v_cmp_lt_i32 s[44:45], 16, v249
    v_cmp_lt_i32 s[48:49], 0, v250
    v_cmp_lt_i32 s[52:53], 16, v250
    v_cmp_lt_i32 s[56:57], 0, v251
    v_cmp_lt_i32 s[60:61], 16, v251
    v_cndmask_b32 v29, v28, v244, s[32:33]
    buffer_load_dwordx4 v[152:155], v29, s[20:23], 0 offen offset:0 sc1
    v_cndmask_b32 v30, v28, v244, s[36:37]
    buffer_load_dwordx4 v[156:159], v30, s[20:23], 0 offen offset:128 sc1
    v_cndmask_b32 v31, v28, v245, s[40:41]
    buffer_load_dwordx4 v[160:163], v31, s[20:23], 0 offen offset:0 sc1
    v_cndmask_b32 v29, v28, v245, s[44:45]
    buffer_load_dwordx4 v[164:167], v29, s[20:23], 0 offen offset:128 sc1
    v_cndmask_b32 v30, v28, v246, s[48:49]
    buffer_load_dwordx4 v[168:171], v30, s[20:23], 0 offen offset:0 sc1
    v_cndmask_b32 v31, v28, v246, s[52:53]
    buffer_load_dwordx4 v[172:175], v31, s[20:23], 0 offen offset:128 sc1
    v_cndmask_b32 v29, v28, v247, s[56:57]
    buffer_load_dwordx4 v[176:179], v29, s[20:23], 0 offen offset:0 sc1
    v_cndmask_b32 v30, v28, v247, s[60:61]
    buffer_load_dwordx4 v[180:183], v30, s[20:23], 0 offen offset:128 sc1
    v_cmp_lt_i32 s[34:35], 1, v248
    v_cmp_lt_i32 s[38:39], 17, v248
    v_cmp_lt_i32 s[42:43], 1, v249
    v_cmp_lt_i32 s[46:47], 17, v249
    v_cmp_lt_i32 s[50:51], 1, v250
    v_cmp_lt_i32 s[54:55], 17, v250
    v_cmp_lt_i32 s[58:59], 1, v251
    v_cmp_lt_i32 s[62:63], 17, v251
    s_waitcnt vmcnt(7)
    v_lshrrev_b32 v200, 27, v153
    v_lshrrev_b32 v201, 27, v155
    s_mov_b64 exec, s[32:33]
    ds_add_rtn_u32 v184, v200, v22 offset:0
    s_mov_b64 exec, s[34:35]
    ds_add_rtn_u32 v185, v201, v22 offset:0
    s_mov_b64 exec, -1
    s_waitcnt vmcnt(6)
    v_lshrrev_b32 v202, 27, v157
    v_lshrrev_b32 v203, 27, v159
    s_mov_b64 exec, s[36:37]
    ds_add_rtn_u32 v186, v202, v22 offset:0
    s_mov_b64 exec, s[38:39]
    ds_add_rtn_u32 v187, v203, v22 offset:0
    s_mov_b64 exec, -1
    s_waitcnt vmcnt(5)
    v_lshrrev_b32 v204, 27, v161
    v_lshrrev_b32 v205, 27, v163
    s_mov_b64 exec, s[40:41]
    ds_add_rtn_u32 v188, v204, v22 offset:0
    s_mov_b64 exec, s[42:43]
    ds_add_rtn_u32 v189, v205, v22 offset:0
    s_mov_b64 exec, -1
    s_waitcnt vmcnt(4)
    v_lshrrev_b32 v206, 27, v165
    v_lshrrev_b32 v207, 27, v167
    s_mov_b64 exec, s[44:45]
    ds_add_rtn_u32 v190, v206, v22 offset:0
    s_mov_b64 exec, s[46:47]
    ds_add_rtn_u32 v191, v207, v22 offset:0
    s_mov_b64 exec, -1
    s_waitcnt vmcnt(3)
    v_lshrrev_b32 v208, 27, v169
    v_lshrrev_b32 v209, 27, v171
    s_mov_b64 exec, s[48:49]
    ds_add_rtn_u32 v192, v208, v22 offset:0
    s_mov_b64 exec, s[50:51]
    ds_add_rtn_u32 v193, v209, v22 offset:0
    s_mov_b64 exec, -1
    s_waitcnt vmcnt(2)
    v_lshrrev_b32 v210, 27, v173
    v_lshrrev_b32 v211, 27, v175
    s_mov_b64 exec, s[52:53]
    ds_add_rtn_u32 v194, v210, v22 offset:0
    s_mov_b64 exec, s[54:55]
    ds_add_rtn_u32 v195, v211, v22 offset:0
    s_mov_b64 exec, -1
    s_waitcnt vmcnt(1)
    v_lshrrev_b32 v212, 27, v177
    v_lshrrev_b32 v213, 27, v179
    s_mov_b64 exec, s[56:57]
    ds_add_rtn_u32 v196, v212, v22 offset:0
    s_mov_b64 exec, s[58:59]
    ds_add_rtn_u32 v197, v213, v22 offset:0
    s_mov_b64 exec, -1
    s_waitcnt vmcnt(0)
    v_lshrrev_b32 v214, 27, v181
    v_lshrrev_b32 v215, 27, v183
    s_mov_b64 exec, s[60:61]
    ds_add_rtn_u32 v198, v214, v22 offset:0
    s_mov_b64 exec, s[62:63]
    ds_add_rtn_u32 v199, v215, v22 offset:0
    s_mov_b64 exec, -1
    v_subrev_u32 v248, 32, v248
    v_add_u32 v244, 0x100, v244
    v_subrev_u32 v249, 32, v249
    v_add_u32 v245, 0x100, v245
    v_subrev_u32 v250, 32, v250
    v_add_u32 v246, 0x100, v246
    v_subrev_u32 v251, 32, v251
    v_add_u32 v247, 0x100, v247
    v_max3_i32 v23, v248, v249, v250
    v_max_i32 v23, v23, v251
    v_cmp_lt_i32 vcc, 0, v23
    s_waitcnt lgkmcnt(0)
    v_min_u32 v184, s69, v184
    v_min_u32 v185, s69, v185
    v_min_u32 v186, s69, v186
    v_min_u32 v187, s69, v187
    v_min_u32 v188, s69, v188
    v_min_u32 v189, s69, v189
    v_min_u32 v190, s69, v190
    v_min_u32 v191, s69, v191
    v_min_u32 v192, s69, v192
    v_min_u32 v193, s69, v193
    v_min_u32 v194, s69, v194
    v_min_u32 v195, s69, v195
    v_min_u32 v196, s69, v196
    v_min_u32 v197, s69, v197
    v_min_u32 v198, s69, v198
    v_min_u32 v199, s69, v199
    s_mov_b64 exec, s[32:33]
    ds_write2st64_b32 v184, v152, v153 offset0:0 offset1:88
    s_mov_b64 exec, s[34:35]
    ds_write2st64_b32 v185, v154, v155 offset0:0 offset1:88
    s_mov_b64 exec, s[36:37]
    ds_write2st64_b32 v186, v156, v157 offset0:0 offset1:88
    s_mov_b64 exec, s[38:39]
    ds_write2st64_b32 v187, v158, v159 offset0:0 offset1:88
    s_mov_b64 exec, s[40:41]
    ds_write2st64_b32 v188, v160, v161 offset0:0 offset1:88
    s_mov_b64 exec, s[42:43]
    ds_write2st64_b32 v189, v162, v163 offset0:0 offset1:88
    s_mov_b64 exec, s[44:45]
    ds_write2st64_b32 v190, v164, v165 offset0:0 offset1:88
    s_mov_b64 exec, s[46:47]
    ds_write2st64_b32 v191, v166, v167 offset0:0 offset1:88
    s_mov_b64 exec, s[48:49]
    ds_write2st64_b32 v192, v168, v169 offset0:0 offset1:88
    s_mov_b64 exec, s[50:51]
    ds_write2st64_b32 v193, v170, v171 offset0:0 offset1:88
    s_mov_b64 exec, s[52:53]
    ds_write2st64_b32 v194, v172, v173 offset0:0 offset1:88
    s_mov_b64 exec, s[54:55]
    ds_write2st64_b32 v195, v174, v175 offset0:0 offset1:88
    s_mov_b64 exec, s[56:57]
    ds_write2st64_b32 v196, v176, v177 offset0:0 offset1:88
    s_mov_b64 exec, s[58:59]
    ds_write2st64_b32 v197, v178, v179 offset0:0 offset1:88
    s_mov_b64 exec, s[60:61]
    ds_write2st64_b32 v198, v180, v181 offset0:0 offset1:88
    s_mov_b64 exec, s[62:63]
    ds_write2st64_b32 v199, v182, v183 offset0:0 offset1:88
    s_mov_b64 exec, -1
    s_waitcnt lgkmcnt(0)
    s_cbranch_vccnz K2_collect
    s_barrier
    s_cmp_lt_u32 s4, 4
    s_cbranch_scc1 K2_counts
    s_lshl_b32 s31, s4, 2
    v_mov_b32 v22, s31
K2_stag:
    ds_read_b32 v23, v22 offset:16
    s_waitcnt lgkmcnt(0)
    v_readfirstlane_b32 s31, v23
    s_sleep 2
    s_cmp_eq_u32 s31, 0
    s_cbranch_scc1 K2_stag
K2_counts:
    ds_read_b128 v[236:239], v8
    ds_read_b32 v244, v17
    ds_read_b128 v[240:243], v8 offset:128
    ds_read_b32 v245, v17 offset:128
    v_and_b32 v22, 7, v0
    v_lshlrev_b32 v23, 2, v22
    ds_read_b32 v23, v23 offset:0
    ds_read_b128 v[28:31], v8 offset:256
    ds_read_b32 v18, v17 offset:256
    ds_read_b32 v19, v9
    v_mul_u32_u24 v22, 2816, v22
    v_add_u32 v22, 105024, v22
    s_waitcnt lgkmcnt(6)
    s_add_u32 m0, s24, 0
    v_xad_u32 v236, v2, 0, v236
    buffer_load_dwordx4 v236, s[8:11], 0 offen lds
    s_add_u32 m0, m0, 0x400
    v_xad_u32 v237, v2, 16, v237
    buffer_load_dwordx4 v237, s[8:11], 0 offen lds
    s_add_u32 m0, m0, 0x400
    v_xad_u32 v238, v2, 32, v238
    buffer_load_dwordx4 v238, s[8:11], 0 offen lds
    s_add_u32 m0, m0, 0x400
    v_xad_u32 v239, v2, 48, v239
    buffer_load_dwordx4 v239, s[8:11], 0 offen lds
    s_add_u32 m0, m0, 0x400
    v_and_or_b32 v244, v244, s25, v16
    buffer_load_dwordx4 v244, s[12:15], 0 offen nt lds
    s_waitcnt lgkmcnt(0)
    s_add_u32 m0, s24, 40960
    v_xad_u32 v240, v2, 0, v240
    buffer_load_dwordx4 v240, s[8:11], 0 offen lds
    s_add_u32 m0, m0, 0x400
    v_xad_u32 v241, v2, 16, v241
    buffer_load_dwordx4 v241, s[8:11], 0 offen lds
    s_add_u32 m0, m0, 0x400
    v_xad_u32 v242, v2, 32, v242
    buffer_load_dwordx4 v242, s[8:11], 0 offen lds
    s_add_u32 m0, m0, 0x400
    v_xad_u32 v243, v2, 48, v243
    buffer_load_dwordx4 v243, s[8:11], 0 offen lds
    s_add_u32 m0, m0, 0x400
    v_and_or_b32 v245, v245, s25, v16
    buffer_load_dwordx4 v245, s[12:15], 0 offen nt lds
    v_sub_u32 v23, v23, v22
    v_lshrrev_b32 v23, 2, v23
    s_waitcnt vmcnt(5)
    s_lshl_b32 s31, s4, 2
    v_mov_b32 v22, s31
    ds_write_b32 v22, v14 offset:32
    v_cmp_lt_u32 vcc, 576, v23
    v_cmp_ne_u32 s[32:33], 0, v23
    v_readlane_b32 s27, v23, s4
    v_and_b32 v19, 31, v19
    v_mad_u32_u24 v20, v19, s26, v11
    v_mad_u32_u24 v21, v19, s26, v12
    ds_read_b128 v[236:239], v20
    ds_read_b128 v[240:243], v20 offset:32
    s_or_b32 s30, s32, s33
    s_cbranch_vccnz K2_slow_init
    s_add_u32 s5, s27, 31
    s_lshr_b32 s5, s5, 5
    s_cmp_eq_u32 s5, 0
    s_cbranch_scc1 K2_main_done
    v_mov_b32 v244, 0
    v_mov_b32 v245, 0
    v_mov_b32 v246, 0
    v_mov_b32 v247, 0
    v_mov_b32 v248, 0
    v_mov_b32 v249, 0
    v_mov_b32 v250, 0
    v_mov_b32 v251, 0
    v_mov_b32 v184, 0
    v_mov_b32 v185, 0
    v_mov_b32 v186, 0
    v_mov_b32 v187, 0
    v_mov_b32 v192, 0
    v_mov_b32 v193, 0
    v_mov_b32 v194, 0
    v_mov_b32 v195, 0
    s_mov_b32 s6, 0
    s_sub_u32 s70, s5, 3
    s_cmp_ge_u32 s4, 4
    s_cselect_b32 s70, -1, s70
    s_waitcnt vmcnt(5)
    ds_read_b128 v[232:235], v3
    ds_read_b128 v[216:219], v4
    ds_read_b128 v[220:223], v5
    ds_read_b128 v[224:227], v6
    ds_read_b128 v[228:231], v7
    s_waitcnt lgkmcnt(0)
    s_add_u32 m0, s24, 0
    v_xad_u32 v28, v2, 0, v28
    buffer_load_dwordx4 v28, s[8:11], 0 offen lds
    s_add_u32 m0, m0, 0x400
    v_xad_u32 v29, v2, 16, v29
    buffer_load_dwordx4 v29, s[8:11], 0 offen lds
    s_add_u32 m0, m0, 0x400
    v_xad_u32 v30, v2, 32, v30
    buffer_load_dwordx4 v30, s[8:11], 0 offen lds
    s_add_u32 m0, m0, 0x400
    v_xad_u32 v31, v2, 48, v31
    buffer_load_dwordx4 v31, s[8:11], 0 offen lds
    s_add_u32 m0, m0, 0x400
    v_and_or_b32 v18, v18, s25, v16
    buffer_load_dwordx4 v18, s[12:15], 0 offen nt lds
    v_mfma_f32_32x32x16_bf16 v[152:167], v[236:239], v[104:107], 0
    v_mfma_f32_32x32x16_bf16 v[152:167], v[240:243], v[112:115], v[152:167]
    v_mfma_f32_32x32x16_bf16 v[152:167], v[232:235], v[64:67], v[152:167]
    v_mfma_f32_32x32x16_bf16 v[152:167], v[216:219], v[32:35], v[152:167]
    v_mfma_f32_32x32x16_bf16 v[168:183], v[216:219], v[72:75], 0
    v_mfma_f32_32x32x16_bf16 v[152:167], v[220:223], v[40:43], v[152:167]
    v_mfma_f32_32x32x16_bf16 v[168:183], v[220:223], v[80:83], v[168:183]
    v_mfma_f32_32x32x16_bf16 v[152:167], v[224:227], v[48:51], v[152:167]
    v_mfma_f32_32x32x16_bf16 v[168:183], v[224:227], v[88:91], v[168:183]
    v_mfma_f32_32x32x16_bf16 v[152:167], v[228:231], v[56:59], v[152:167]
    v_mfma_f32_32x32x16_bf16 v[168:183], v[228:231], v[96:99], v[168:183]
    s_nop 7
    s_nop 3
K2_loop:
    v_mfma_f32_32x32x16_bf16 v[136:151], v[244:247], v[184:187], v[136:151]
    ds_read_b32 v19, v9 offset:128
    v_exp_f32 v152, v152
    v_exp_f32 v153, v153
    v_exp_f32 v154, v154
    v_exp_f32 v155, v155
    v_mfma_f32_32x32x16_bf16 v[136:151], v[248:251], v[192:195], v[136:151]
    ds_write_b16 v21, v14
    ds_read_b128 v[244:247], v13
    ds_read_b128 v[248:251], v13 offset:32
    ds_write_b16 v21, v15
    v_add_f32 v152, 1.0, v152
    v_add_f32 v153, 1.0, v153
    v_add_f32 v154, 1.0, v154
    v_add_f32 v155, 1.0, v155
    v_rcp_f32 v152, v152
    v_rcp_f32 v153, v153
    v_mfma_f32_32x32x16_bf16 v[184:199], v[236:239], v[108:111], 0
    v_rcp_f32 v154, v154
    v_rcp_f32 v155, v155
    v_mul_f32 v152, v152, v168
    v_mul_f32 v153, v153, v169
    v_mul_f32 v154, v154, v170
    v_mfma_f32_32x32x16_bf16 v[184:199], v[240:243], v[116:119], v[184:199]
    s_waitcnt lgkmcnt(4)
    v_and_b32 v19, 31, v19
    v_mad_u32_u24 v20, v19, s26, v11
    v_mad_u32_u24 v21, v19, s26, v12
    ds_read_b128 v[236:239], v20
    ds_read_b128 v[240:243], v20 offset:32
    v_mul_f32 v155, v155, v171
    v_cvt_pk_bf16_f32 v152, v152, v153
    v_cvt_pk_bf16_f32 v153, v154, v155
    v_exp_f32 v156, v156
    v_exp_f32 v157, v157
    v_mfma_f32_32x32x16_bf16 v[184:199], v[232:235], v[68:71], v[184:199]
    s_waitcnt vmcnt(5)
    ds_read_b128 v[232:235], v3 offset:40960
    v_exp_f32 v158, v158
    v_exp_f32 v159, v159
    v_add_f32 v156, 1.0, v156
    v_add_f32 v157, 1.0, v157
    v_add_f32 v158, 1.0, v158
    v_add_f32 v159, 1.0, v159
    v_mfma_f32_32x32x16_bf16 v[184:199], v[216:219], v[36:39], v[184:199]
    v_rcp_f32 v156, v156
    v_rcp_f32 v157, v157
    v_rcp_f32 v158, v158
    v_rcp_f32 v159, v159
    v_mfma_f32_32x32x16_bf16 v[200:215], v[216:219], v[76:79], 0
    ds_read_b128 v[216:219], v4 offset:40960
    v_mul_f32 v156, v156, v172
    v_mul_f32 v157, v157, v173
    v_mul_f32 v158, v158, v174
    v_mul_f32 v159, v159, v175
    v_cvt_pk_bf16_f32 v154, v156, v157
    v_cvt_pk_bf16_f32 v155, v158, v159
    v_exp_f32 v160, v160
    v_mfma_f32_32x32x16_bf16 v[184:199], v[220:223], v[44:47], v[184:199]
    v_exp_f32 v161, v161
    v_exp_f32 v162, v162
    v_exp_f32 v163, v163
    v_mfma_f32_32x32x16_bf16 v[200:215], v[220:223], v[84:87], v[200:215]
    ds_read_b128 v[220:223], v5 offset:40960
    v_add_f32 v160, 1.0, v160
    v_add_f32 v161, 1.0, v161
    v_add_f32 v162, 1.0, v162
    v_add_f32 v163, 1.0, v163
    v_rcp_f32 v160, v160
    v_rcp_f32 v161, v161
    v_mfma_f32_32x32x16_bf16 v[184:199], v[224:227], v[52:55], v[184:199]
    v_rcp_f32 v162, v162
    v_rcp_f32 v163, v163
    v_mul_f32 v160, v160, v176
    v_mul_f32 v161, v161, v177
    v_mul_f32 v162, v162, v178
    v_mfma_f32_32x32x16_bf16 v[200:215], v[224:227], v[92:95], v[200:215]
    ds_read_b128 v[224:227], v6 offset:40960
    ds_read_b128 v[28:31], v8 offset:384
    ds_read_b32 v18, v17 offset:384
    v_mul_f32 v163, v163, v179
    v_cvt_pk_bf16_f32 v160, v160, v161
    v_cvt_pk_bf16_f32 v161, v162, v163
    v_exp_f32 v164, v164
    v_exp_f32 v165, v165
    v_exp_f32 v166, v166
    v_mfma_f32_32x32x16_bf16 v[184:199], v[228:231], v[60:63], v[184:199]
    v_exp_f32 v167, v167
    v_add_f32 v164, 1.0, v164
    v_add_f32 v165, 1.0, v165
    v_add_f32 v166, 1.0, v166
    v_add_f32 v167, 1.0, v167
    v_mfma_f32_32x32x16_bf16 v[200:215], v[228:231], v[100:103], v[200:215]
    ds_read_b128 v[228:231], v7 offset:40960
    v_rcp_f32 v164, v164
    v_rcp_f32 v165, v165
    v_rcp_f32 v166, v166
    v_rcp_f32 v167, v167
    v_mul_f32 v164, v164, v180
    v_mul_f32 v165, v165, v181
    v_mul_f32 v166, v166, v182
    v_mul_f32 v167, v167, v183
    v_cvt_pk_bf16_f32 v162, v164, v165
    v_cvt_pk_bf16_f32 v163, v166, v167
    s_waitcnt lgkmcnt(1)
    v_mfma_f32_32x32x16_bf16 v[120:135], v[244:247], v[152:155], v[120:135]
    v_exp_f32 v184, v184
    v_exp_f32 v185, v185
    v_exp_f32 v186, v186
    v_exp_f32 v187, v187
    v_mfma_f32_32x32x16_bf16 v[120:135], v[248:251], v[160:163], v[120:135]
    s_waitcnt lgkmcnt(0)
    s_add_u32 m0, s24, 40960
    v_xad_u32 v28, v2, 0, v28
    buffer_load_dwordx4 v28, s[8:11], 0 offen lds
    s_add_u32 m0, m0, 0x400
    v_add_f32 v184, 1.0, v184
    v_add_f32 v185, 1.0, v185
    v_add_f32 v186, 1.0, v186
    v_add_f32 v187, 1.0, v187
    v_rcp_f32 v184, v184
    v_rcp_f32 v185, v185
    v_mfma_f32_32x32x16_bf16 v[152:167], v[236:239], v[104:107], 0
    v_xad_u32 v29, v2, 16, v29
    buffer_load_dwordx4 v29, s[8:11], 0 offen lds
    s_add_u32 m0, m0, 0x400
    v_rcp_f32 v186, v186
    v_rcp_f32 v187, v187
    v_mul_f32 v184, v184, v200
    v_mul_f32 v185, v185, v201
    v_mul_f32 v186, v186, v202
    v_mfma_f32_32x32x16_bf16 v[152:167], v[240:243], v[112:115], v[152:167]
    v_xad_u32 v30, v2, 32, v30
    buffer_load_dwordx4 v30, s[8:11], 0 offen lds
    s_add_u32 m0, m0, 0x400
    v_mul_f32 v187, v187, v203
    v_cvt_pk_bf16_f32 v184, v184, v185
    v_cvt_pk_bf16_f32 v185, v186, v187
    v_exp_f32 v188, v188
    v_exp_f32 v189, v189
    v_mfma_f32_32x32x16_bf16 v[152:167], v[232:235], v[64:67], v[152:167]
    v_xad_u32 v31, v2, 48, v31
    buffer_load_dwordx4 v31, s[8:11], 0 offen lds
    s_add_u32 m0, m0, 0x400
    v_exp_f32 v190, v190
    v_exp_f32 v191, v191
    v_add_f32 v188, 1.0, v188
    v_add_f32 v189, 1.0, v189
    v_add_f32 v190, 1.0, v190
    v_add_f32 v191, 1.0, v191
    v_mfma_f32_32x32x16_bf16 v[152:167], v[216:219], v[32:35], v[152:167]
    v_and_or_b32 v18, v18, s25, v16
    buffer_load_dwordx4 v18, s[12:15], 0 offen nt lds
    v_rcp_f32 v188, v188
    v_rcp_f32 v189, v189
    v_rcp_f32 v190, v190
    v_rcp_f32 v191, v191
    v_mfma_f32_32x32x16_bf16 v[168:183], v[216:219], v[72:75], 0
    v_mul_f32 v188, v188, v204
    v_mul_f32 v189, v189, v205
    v_mul_f32 v190, v190, v206
    v_mul_f32 v191, v191, v207
    v_cvt_pk_bf16_f32 v186, v188, v189
    v_cvt_pk_bf16_f32 v187, v190, v191
    v_exp_f32 v192, v192
    v_mfma_f32_32x32x16_bf16 v[152:167], v[220:223], v[40:43], v[152:167]
    v_exp_f32 v193, v193
    v_exp_f32 v194, v194
    v_exp_f32 v195, v195
    v_mfma_f32_32x32x16_bf16 v[168:183], v[220:223], v[80:83], v[168:183]
    v_add_f32 v192, 1.0, v192
    v_add_f32 v193, 1.0, v193
    v_add_f32 v194, 1.0, v194
    v_add_f32 v195, 1.0, v195
    v_rcp_f32 v192, v192
    v_rcp_f32 v193, v193
    v_mfma_f32_32x32x16_bf16 v[152:167], v[224:227], v[48:51], v[152:167]
    v_rcp_f32 v194, v194
    v_rcp_f32 v195, v195
    v_mul_f32 v192, v192, v208
    v_mul_f32 v193, v193, v209
    v_mul_f32 v194, v194, v210
    v_mfma_f32_32x32x16_bf16 v[168:183], v[224:227], v[88:91], v[168:183]
    v_mul_f32 v195, v195, v211
    v_cvt_pk_bf16_f32 v192, v192, v193
    v_cvt_pk_bf16_f32 v193, v194, v195
    v_exp_f32 v196, v196
    v_exp_f32 v197, v197
    v_exp_f32 v198, v198
    v_mfma_f32_32x32x16_bf16 v[152:167], v[228:231], v[56:59], v[152:167]
    v_exp_f32 v199, v199
    v_add_f32 v196, 1.0, v196
    v_add_f32 v197, 1.0, v197
    v_add_f32 v198, 1.0, v198
    v_add_f32 v199, 1.0, v199
    v_mfma_f32_32x32x16_bf16 v[168:183], v[228:231], v[96:99], v[168:183]
    v_rcp_f32 v196, v196
    v_rcp_f32 v197, v197
    v_rcp_f32 v198, v198
    v_rcp_f32 v199, v199
    v_mul_f32 v196, v196, v212
    v_mul_f32 v197, v197, v213
    v_mul_f32 v198, v198, v214
    v_mul_f32 v199, v199, v215
    v_cvt_pk_bf16_f32 v194, v196, v197
    v_cvt_pk_bf16_f32 v195, v198, v199
    s_add_u32 s6, s6, 1
    s_cmp_lg_u32 s6, s70
    s_cbranch_scc1 K2_np0
    s_setprio 0
K2_np0:
    s_cmp_ge_u32 s6, s5
    s_cbranch_scc1 K2_loop_exit
    v_mfma_f32_32x32x16_bf16 v[136:151], v[244:247], v[184:187], v[136:151]
    ds_read_b32 v19, v9 offset:256
    v_exp_f32 v152, v152
    v_exp_f32 v153, v153
    v_exp_f32 v154, v154
    v_exp_f32 v155, v155
    v_mfma_f32_32x32x16_bf16 v[136:151], v[248:251], v[192:195], v[136:151]
    ds_write_b16 v21, v14
    ds_read_b128 v[244:247], v13
    ds_read_b128 v[248:251], v13 offset:32
    ds_write_b16 v21, v15
    v_add_f32 v152, 1.0, v152
    v_add_f32 v153, 1.0, v153
    v_add_f32 v154, 1.0, v154
    v_add_f32 v155, 1.0, v155
    v_rcp_f32 v152, v152
    v_rcp_f32 v153, v153
    v_mfma_f32_32x32x16_bf16 v[184:199], v[236:239], v[108:111], 0
    v_rcp_f32 v154, v154
    v_rcp_f32 v155, v155
    v_mul_f32 v152, v152, v168
    v_mul_f32 v153, v153, v169
    v_mul_f32 v154, v154, v170
    v_mfma_f32_32x32x16_bf16 v[184:199], v[240:243], v[116:119], v[184:199]
    s_waitcnt lgkmcnt(4)
    v_and_b32 v19, 31, v19
    v_mad_u32_u24 v20, v19, s26, v11
    v_mad_u32_u24 v21, v19, s26, v12
    ds_read_b128 v[236:239], v20
    ds_read_b128 v[240:243], v20 offset:32
    v_mul_f32 v155, v155, v171
    v_cvt_pk_bf16_f32 v152, v152, v153
    v_cvt_pk_bf16_f32 v153, v154, v155
    v_exp_f32 v156, v156
    v_exp_f32 v157, v157
    v_mfma_f32_32x32x16_bf16 v[184:199], v[232:235], v[68:71], v[184:199]
    s_waitcnt vmcnt(5)
    ds_read_b128 v[232:235], v3 offset:0
    v_exp_f32 v158, v158
    v_exp_f32 v159, v159
    v_add_f32 v156, 1.0, v156
    v_add_f32 v157, 1.0, v157
    v_add_f32 v158, 1.0, v158
    v_add_f32 v159, 1.0, v159
    v_mfma_f32_32x32x16_bf16 v[184:199], v[216:219], v[36:39], v[184:199]
    v_rcp_f32 v156, v156
    v_rcp_f32 v157, v157
    v_rcp_f32 v158, v158
    v_rcp_f32 v159, v159
    v_mfma_f32_32x32x16_bf16 v[200:215], v[216:219], v[76:79], 0
    ds_read_b128 v[216:219], v4 offset:0
    v_mul_f32 v156, v156, v172
    v_mul_f32 v157, v157, v173
    v_mul_f32 v158, v158, v174
    v_mul_f32 v159, v159, v175
    v_cvt_pk_bf16_f32 v154, v156, v157
    v_cvt_pk_bf16_f32 v155, v158, v159
    v_exp_f32 v160, v160
    v_mfma_f32_32x32x16_bf16 v[184:199], v[220:223], v[44:47], v[184:199]
    v_exp_f32 v161, v161
    v_exp_f32 v162, v162
    v_exp_f32 v163, v163
    v_mfma_f32_32x32x16_bf16 v[200:215], v[220:223], v[84:87], v[200:215]
    ds_read_b128 v[220:223], v5 offset:0
    v_add_f32 v160, 1.0, v160
    v_add_f32 v161, 1.0, v161
    v_add_f32 v162, 1.0, v162
    v_add_f32 v163, 1.0, v163
    v_rcp_f32 v160, v160
    v_rcp_f32 v161, v161
    v_mfma_f32_32x32x16_bf16 v[184:199], v[224:227], v[52:55], v[184:199]
    v_rcp_f32 v162, v162
    v_rcp_f32 v163, v163
    v_mul_f32 v160, v160, v176
    v_mul_f32 v161, v161, v177
    v_mul_f32 v162, v162, v178
    v_mfma_f32_32x32x16_bf16 v[200:215], v[224:227], v[92:95], v[200:215]
    ds_read_b128 v[224:227], v6 offset:0
    ds_read_b128 v[28:31], v8 offset:512
    ds_read_b32 v18, v17 offset:512
    v_mul_f32 v163, v163, v179
    v_cvt_pk_bf16_f32 v160, v160, v161
    v_cvt_pk_bf16_f32 v161, v162, v163
    v_exp_f32 v164, v164
    v_exp_f32 v165, v165
    v_exp_f32 v166, v166
    v_mfma_f32_32x32x16_bf16 v[184:199], v[228:231], v[60:63], v[184:199]
    v_exp_f32 v167, v167
    v_add_f32 v164, 1.0, v164
    v_add_f32 v165, 1.0, v165
    v_add_f32 v166, 1.0, v166
    v_add_f32 v167, 1.0, v167
    v_mfma_f32_32x32x16_bf16 v[200:215], v[228:231], v[100:103], v[200:215]
    ds_read_b128 v[228:231], v7 offset:0
    v_rcp_f32 v164, v164
    v_rcp_f32 v165, v165
    v_rcp_f32 v166, v166
    v_rcp_f32 v167, v167
    v_mul_f32 v164, v164, v180
    v_mul_f32 v165, v165, v181
    v_mul_f32 v166, v166, v182
    v_mul_f32 v167, v167, v183
    v_cvt_pk_bf16_f32 v162, v164, v165
    v_cvt_pk_bf16_f32 v163, v166, v167
    s_waitcnt lgkmcnt(1)
    v_mfma_f32_32x32x16_bf16 v[120:135], v[244:247], v[152:155], v[120:135]
    v_exp_f32 v184, v184
    v_exp_f32 v185, v185
    v_exp_f32 v186, v186
    v_exp_f32 v187, v187
    v_mfma_f32_32x32x16_bf16 v[120:135], v[248:251], v[160:163], v[120:135]
    s_waitcnt lgkmcnt(0)
    s_add_u32 m0, s24, 0
    v_xad_u32 v28, v2, 0, v28
    buffer_load_dwordx4 v28, s[8:11], 0 offen lds
    s_add_u32 m0, m0, 0x400
    v_add_f32 v184, 1.0, v184
    v_add_f32 v185, 1.0, v185
    v_add_f32 v186, 1.0, v186
    v_add_f32 v187, 1.0, v187
    v_rcp_f32 v184, v184
    v_rcp_f32 v185, v185
    v_mfma_f32_32x32x16_bf16 v[152:167], v[236:239], v[104:107], 0
    v_xad_u32 v29, v2, 16, v29
    buffer_load_dwordx4 v29, s[8:11], 0 offen lds
    s_add_u32 m0, m0, 0x400
    v_rcp_f32 v186, v186
    v_rcp_f32 v187, v187
    v_mul_f32 v184, v184, v200
    v_mul_f32 v185, v185, v201
    v_mul_f32 v186, v186, v202
    v_mfma_f32_32x32x16_bf16 v[152:167], v[240:243], v[112:115], v[152:167]
    v_xad_u32 v30, v2, 32, v30
    buffer_load_dwordx4 v30, s[8:11], 0 offen lds
    s_add_u32 m0, m0, 0x400
    v_mul_f32 v187, v187, v203
    v_cvt_pk_bf16_f32 v184, v184, v185
    v_cvt_pk_bf16_f32 v185, v186, v187
    v_exp_f32 v188, v188
    v_exp_f32 v189, v189
    v_mfma_f32_32x32x16_bf16 v[152:167], v[232:235], v[64:67], v[152:167]
    v_xad_u32 v31, v2, 48, v31
    buffer_load_dwordx4 v31, s[8:11], 0 offen lds
    s_add_u32 m0, m0, 0x400
    v_exp_f32 v190, v190
    v_exp_f32 v191, v191
    v_add_f32 v188, 1.0, v188
    v_add_f32 v189, 1.0, v189
    v_add_f32 v190, 1.0, v190
    v_add_f32 v191, 1.0, v191
    v_mfma_f32_32x32x16_bf16 v[152:167], v[216:219], v[32:35], v[152:167]
    v_and_or_b32 v18, v18, s25, v16
    buffer_load_dwordx4 v18, s[12:15], 0 offen nt lds
    v_rcp_f32 v188, v188
    v_rcp_f32 v189, v189
    v_rcp_f32 v190, v190
    v_rcp_f32 v191, v191
    v_mfma_f32_32x32x16_bf16 v[168:183], v[216:219], v[72:75], 0
    v_mul_f32 v188, v188, v204
    v_mul_f32 v189, v189, v205
    v_mul_f32 v190, v190, v206
    v_mul_f32 v191, v191, v207
    v_cvt_pk_bf16_f32 v186, v188, v189
    v_cvt_pk_bf16_f32 v187, v190, v191
    v_exp_f32 v192, v192
    v_mfma_f32_32x32x16_bf16 v[152:167], v[220:223], v[40:43], v[152:167]
    v_exp_f32 v193, v193
    v_exp_f32 v194, v194
    v_exp_f32 v195, v195
    v_mfma_f32_32x32x16_bf16 v[168:183], v[220:223], v[80:83], v[168:183]
    v_add_f32 v192, 1.0, v192
    v_add_f32 v193, 1.0, v193
    v_add_f32 v194, 1.0, v194
    v_add_f32 v195, 1.0, v195
    v_rcp_f32 v192, v192
    v_rcp_f32 v193, v193
    v_mfma_f32_32x32x16_bf16 v[152:167], v[224:227], v[48:51], v[152:167]
    v_rcp_f32 v194, v194
    v_rcp_f32 v195, v195
    v_mul_f32 v192, v192, v208
    v_mul_f32 v193, v193, v209
    v_mul_f32 v194, v194, v210
    v_mfma_f32_32x32x16_bf16 v[168:183], v[224:227], v[88:91], v[168:183]
    v_mul_f32 v195, v195, v211
    v_cvt_pk_bf16_f32 v192, v192, v193
    v_cvt_pk_bf16_f32 v193, v194, v195
    v_exp_f32 v196, v196
    v_exp_f32 v197, v197
    v_exp_f32 v198, v198
    v_mfma_f32_32x32x16_bf16 v[152:167], v[228:231], v[56:59], v[152:167]
    v_exp_f32 v199, v199
    v_add_f32 v196, 1.0, v196
    v_add_f32 v197, 1.0, v197
    v_add_f32 v198, 1.0, v198
    v_add_f32 v199, 1.0, v199
    v_mfma_f32_32x32x16_bf16 v[168:183], v[228:231], v[96:99], v[168:183]
    v_rcp_f32 v196, v196
    v_rcp_f32 v197, v197
    v_rcp_f32 v198, v198
    v_rcp_f32 v199, v199
    v_mul_f32 v196, v196, v212
    v_mul_f32 v197, v197, v213
    v_mul_f32 v198, v198, v214
    v_mul_f32 v199, v199, v215
    v_cvt_pk_bf16_f32 v194, v196, v197
    v_cvt_pk_bf16_f32 v195, v198, v199
    v_add_u32 v8, 0x100, v8
    v_add_u32 v9, 0x100, v9
    v_add_u32 v17, 0x100, v17
    s_add_u32 s6, s6, 1
    s_cmp_lg_u32 s6, s70
    s_cbranch_scc1 K2_np1
    s_setprio 0
K2_np1:
    s_cmp_lt_u32 s6, s5
    s_cbranch_scc1 K2_loop
K2_loop_exit:
    s_nop 1
    v_mfma_f32_32x32x16_bf16 v[136:151], v[244:247], v[184:187], v[136:151]
    v_mfma_f32_32x32x16_bf16 v[136:151], v[248:251], v[192:195], v[136:151]
    s_lshr_b32 s31, s6, 1
    s_lshl_b32 s31, s31, 8
    v_subrev_u32 v8, s31, v8
    v_subrev_u32 v9, s31, v9
    v_subrev_u32 v17, s31, v17
K2_main_done:
    s_cmp_lg_u32 s7, 0
    s_cbranch_scc1 K2_slow_next
K2_epi:
    s_nop 7
    s_nop 7
    v_and_b32 v22, 31, v0
    v_lshlrev_b32 v22, 2, v22
    v_lshl_add_u32 v22, v10, 5, v22
    v_mul_f32 v152, s66, v120
    v_mul_f32 v153, s66, v136
    v_mul_f32 v154, s66, v121
    v_mul_f32 v155, s66, v137
    v_mul_f32 v156, s66, v122
    v_mul_f32 v157, s66, v138
    v_mul_f32 v158, s66, v123
    v_mul_f32 v159, s66, v139
    v_mul_f32 v160, s66, v124
    v_mul_f32 v161, s66, v140
    v_mul_f32 v162, s66, v125
    v_mul_f32 v163, s66, v141
    v_mul_f32 v164, s66, v126
    v_mul_f32 v165, s66, v142
    v_mul_f32 v166, s66, v127
    v_mul_f32 v167, s66, v143
    v_mul_f32 v168, s66, v128
    v_mul_f32 v169, s66, v144
    v_mul_f32 v170, s66, v129
    v_mul_f32 v171, s66, v145
    v_mul_f32 v172, s66, v130
    v_mul_f32 v173, s66, v146
    v_mul_f32 v174, s66, v131
    v_mul_f32 v175, s66, v147
    v_mul_f32 v176, s66, v132
    v_mul_f32 v177, s66, v148
    v_exp_f32 v152, v152
    v_exp_f32 v153, v153
    v_exp_f32 v154, v154
    v_exp_f32 v155, v155
    v_exp_f32 v156, v156
    v_exp_f32 v157, v157
    v_exp_f32 v158, v158
    v_exp_f32 v159, v159
    v_exp_f32 v160, v160
    v_exp_f32 v161, v161
    v_exp_f32 v162, v162
    v_exp_f32 v163, v163
    v_exp_f32 v164, v164
    v_exp_f32 v165, v165
    v_exp_f32 v166, v166
    v_exp_f32 v167, v167
    v_exp_f32 v168, v168
    v_exp_f32 v169, v169
    v_exp_f32 v170, v170
    v_exp_f32 v171, v171
    v_exp_f32 v172, v172
    v_exp_f32 v173, v173
    v_exp_f32 v174, v174
    v_exp_f32 v175, v175
    v_exp_f32 v176, v176
    v_exp_f32 v177, v177
    v_add_f32 v152, 1.0, v152
    v_add_f32 v153, 1.0, v153
    v_add_f32 v154, 1.0, v154
    v_add_f32 v155, 1.0, v155
    v_add_f32 v156, 1.0, v156
    v_add_f32 v157, 1.0, v157
    v_add_f32 v158, 1.0, v158
    v_add_f32 v159, 1.0, v159
    v_add_f32 v160, 1.0, v160
    v_add_f32 v161, 1.0, v161
    v_add_f32 v162, 1.0, v162
    v_add_f32 v163, 1.0, v163
    v_add_f32 v164, 1.0, v164
    v_add_f32 v165, 1.0, v165
    v_add_f32 v166, 1.0, v166
    v_add_f32 v167, 1.0, v167
    v_add_f32 v168, 1.0, v168
    v_add_f32 v169, 1.0, v169
    v_add_f32 v170, 1.0, v170
    v_add_f32 v171, 1.0, v171
    v_add_f32 v172, 1.0, v172
    v_add_f32 v173, 1.0, v173
    v_add_f32 v174, 1.0, v174
    v_add_f32 v175, 1.0, v175
    v_add_f32 v176, 1.0, v176
    v_add_f32 v177, 1.0, v177
    v_rcp_f32 v152, v152
    v_rcp_f32 v153, v153
    v_rcp_f32 v154, v154
    v_rcp_f32 v155, v155
    v_rcp_f32 v156, v156
    v_rcp_f32 v157, v157
    v_rcp_f32 v158, v158
    v_rcp_f32 v159, v159
    v_rcp_f32 v160, v160
    v_rcp_f32 v161, v161
    v_rcp_f32 v162, v162
    v_rcp_f32 v163, v163
    v_rcp_f32 v164, v164
    v_rcp_f32 v165, v165
    v_rcp_f32 v166, v166
    v_rcp_f32 v167, v167
    v_rcp_f32 v168, v168
    v_rcp_f32 v169, v169
    v_rcp_f32 v170, v170
    v_rcp_f32 v171, v171
    v_rcp_f32 v172, v172
    v_rcp_f32 v173, v173
    v_rcp_f32 v174, v174
    v_rcp_f32 v175, v175
    v_rcp_f32 v176, v176
    v_rcp_f32 v177, v177
    v_mul_f32 v152, v152, v120
    v_mul_f32 v153, v153, v136
    v_mul_f32 v154, v154, v121
    v_mul_f32 v155, v155, v137
    v_mul_f32 v156, v156, v122
    v_mul_f32 v157, v157, v138
    v_mul_f32 v158, v158, v123
    v_mul_f32 v159, v159, v139
    v_mul_f32 v160, v160, v124
    v_mul_f32 v161, v161, v140
    v_mul_f32 v162, v162, v125
    v_mul_f32 v163, v163, v141
    v_mul_f32 v164, v164, v126
    v_mul_f32 v165, v165, v142
    v_mul_f32 v166, v166, v127
    v_mul_f32 v167, v167, v143
    v_mul_f32 v168, v168, v128
    v_mul_f32 v169, v169, v144
    v_mul_f32 v170, v170, v129
    v_mul_f32 v171, v171, v145
    v_mul_f32 v172, v172, v130
    v_mul_f32 v173, v173, v146
    v_mul_f32 v174, v174, v131
    v_mul_f32 v175, v175, v147
    v_mul_f32 v176, v176, v132
    v_mul_f32 v177, v177, v148
    v_cvt_pk_bf16_f32 v184, v152, v153
    v_cvt_pk_bf16_f32 v185, v154, v155
    v_cvt_pk_bf16_f32 v186, v156, v157
    v_cvt_pk_bf16_f32 v187, v158, v159
    v_cvt_pk_bf16_f32 v188, v160, v161
    v_cvt_pk_bf16_f32 v189, v162, v163
    v_cvt_pk_bf16_f32 v190, v164, v165
    v_cvt_pk_bf16_f32 v191, v166, v167
    v_cvt_pk_bf16_f32 v192, v168, v169
    v_cvt_pk_bf16_f32 v193, v170, v171
    v_cvt_pk_bf16_f32 v194, v172, v173
    v_cvt_pk_bf16_f32 v195, v174, v175
    v_cvt_pk_bf16_f32 v196, v176, v177
    buffer_store_dword v184, v22, s[16:19], s68 offen offset:0
    buffer_store_dword v185, v22, s[16:19], s68 offen offset:128
    buffer_store_dword v186, v22, s[16:19], s68 offen offset:256
    buffer_store_dword v187, v22, s[16:19], s68 offen offset:384
    buffer_store_dword v188, v22, s[16:19], s68 offen offset:1024
    buffer_store_dword v189, v22, s[16:19], s68 offen offset:1152
    buffer_store_dword v190, v22, s[16:19], s68 offen offset:1280
    buffer_store_dword v191, v22, s[16:19], s68 offen offset:1408
    buffer_store_dword v192, v22, s[16:19], s68 offen offset:2048
    buffer_store_dword v193, v22, s[16:19], s68 offen offset:2176
    buffer_store_dword v194, v22, s[16:19], s68 offen offset:2304
    buffer_store_dword v195, v22, s[16:19], s68 offen offset:2432
    s_mov_b64 exec, 0xffffffff
    buffer_store_dword v196, v22, s[16:19], s68 offen offset:3072
K2_end:
    s_endpgm
K2_slow_init:
    s_mov_b32 s7, 1
    s_mov_b32 s28, 0
    s_mov_b32 s29, 0
    s_branch K2_slow_batch
K2_slow_next:
    s_add_u32 s29, s29, 1
    s_cmp_lg_u32 s30, 0
    s_cbranch_scc1 K2_slow_batch
    s_mov_b32 s29, 0
    s_add_u32 s28, s28, 1
    s_cmp_ge_u32 s28, 4
    s_cbranch_scc1 K2_epi
K2_slow_batch:
    s_waitcnt vmcnt(0) lgkmcnt(0)
    s_barrier
    s_cmp_lg_u32 s4, 0
    s_cbranch_scc1 K2_slow_nocnt
    v_and_b32 v18, 63, v0
    v_and_b32 v29, 7, v18
    v_mul_u32_u24 v20, 2816, v29
    v_add_u32 v20, 105024, v20
    v_lshlrev_b32 v29, 2, v29
    ds_write_b32 v29, v20 offset:0
K2_slow_nocnt:
    v_mov_b32 v200, 0x7fffff80
    v_mov_b32 v204, 0x1ffffff9
    v_mov_b32 v201, 0x7fffff80
    v_mov_b32 v205, 0x1ffffff9
    v_mov_b32 v202, 0x7fffff80
    v_mov_b32 v206, 0x1ffffff9
    v_mov_b32 v203, 0x7fffff80
    v_mov_b32 v207, 0x1ffffff9
    v_lshlrev_b32 v208, 4, v0
    v_add_u32 v209, 0x4000, v208
    v_min_u32 v209, 22512, v209
    v_add_u32 v208, 105024, v208
    v_add_u32 v209, 105024, v209
    ds_write_b128 v208, v[200:203] offset:0
    ds_write_b128 v208, v[200:203] offset:8192
    ds_write_b128 v209, v[200:203] offset:0
    ds_write_b128 v208, v[204:207] offset:22528
    ds_write_b128 v208, v[204:207] offset:30720
    ds_write_b128 v209, v[204:207] offset:22528
    v_lshrrev_b32 v20, 3, v0
    v_and_b32 v21, 7, v0
    v_lshlrev_b32 v22, 11, v20
    s_lshl_b32 s31, s28, 17
    s_add_u32 s31, s31, s67
    buffer_load_dword v23, v22, s[20:23], s31 offen sc1
    s_lshl_b32 s31, s28, 6
    v_add_u32 v20, s31, v20
    s_lshl_b32 s64, s29, 3
    v_add_u32 v21, s64, v21
    v_cmp_gt_u32 vcc, 250, v20
    v_mul_u32_u24 v20, 3216, v20
    v_add_u32 v20, v20, v21
    s_waitcnt vmcnt(0) lgkmcnt(0)
    s_barrier
    v_cndmask_b32 v23, 0, v23, vcc
    v_bfe_u32 v22, v23, 12, 12
    v_and_b32 v23, 0xfff, v23
    v_add_lshl_u32 v20, v20, v23, 3
    v_cmp_lt_u32 vcc, v21, v22
    v_mov_b32 v28, 0x7ffffff0
    s_nop 1
    v_cndmask_b32 v20, v28, v20, vcc
    buffer_load_dwordx2 v[30:31], v20, s[20:23], 0 offen sc1
    v_mov_b32 v22, 4
    s_waitcnt vmcnt(0)
    v_lshrrev_b32 v20, 27, v31
    s_mov_b64 exec, vcc
    ds_add_rtn_u32 v21, v20, v22 offset:0
    s_waitcnt lgkmcnt(0)
    ds_write2st64_b32 v21, v30, v31 offset0:0 offset1:88
    s_mov_b64 exec, -1
    s_waitcnt lgkmcnt(0)
    s_barrier
    s_branch K2_counts
.section .rodata,"a"
.p2align 6
.amdhsa_kernel standalone__edge_featured_mpnn_egc__graph_kernel
  .amdhsa_next_free_vgpr 252
  .amdhsa_next_free_sgpr 72
  .amdhsa_accum_offset 252
  .amdhsa_group_segment_fixed_size 0
  .amdhsa_kernarg_size 80
  .amdhsa_user_sgpr_count 2
  .amdhsa_user_sgpr_kernarg_segment_ptr 1
  .amdhsa_system_sgpr_workgroup_id_x 1
.end_amdhsa_kernel
```
